```python
import torch

def _softmax(x, axis=-1):
    return torch.softmax(x, dim=axis)
def _gelu(x):
    return torch.nn.functional.gelu(x, approximate="tanh")
def _silu(x):
    return torch.nn.functional.silu(x)
def _sigmoid(x):
    return torch.sigmoid(x)
def _layernorm(x, axis=-1, eps=1e-5):
    m = x.mean(dim=axis, keepdim=True)
    v = x.var(dim=axis, keepdim=True, unbiased=False)
    return (x - m) / torch.sqrt(v + eps)
def _scatter_add(tgt, idx, src, axis=0):
    return tgt.clone().index_add_(axis, idx, src)
def _segment_sum(src, seg, n):
    out = torch.zeros((n,) + src.shape[1:], dtype=src.dtype)
    return out.index_add_(0, seg, src)
def _pad(x, pw):
    flat = tuple(v for pair in reversed(pw) for v in pair)
    return torch.nn.functional.pad(x, flat)

kernel_name = 'gated_mix__sliding_block_cached__sliding_block_cached__decode'

def setup_inputs():

    _w = (lambda a: (lambda t: t.to(torch.bfloat16) if t.is_floating_point() else t)(torch.as_tensor(a)))
    def _A_setup():
        B, Sq, D = 8, 1, 512
        Hq, Hkv, Sk, Dh = 32, 8, 8192, 128
        assert Hq % Hkv == 0, (Hq, Hkv)
        return {
            "x": _w((lambda *s: torch.randn(*s, dtype=torch.bfloat16) * 0.05)(B, Sq, D)),
            "k_cache": _w((lambda *s: torch.randn(*s, dtype=torch.bfloat16) * 6.4)(B, Hkv, Sk, Dh)),
            "v_cache": _w((lambda *s: torch.randn(*s, dtype=torch.bfloat16) * 0.05)(B, Hkv, Sk, Dh)),
            "wq": _w((lambda *s: torch.randn(*s, dtype=torch.bfloat16) * 6.4)(D, Hq * Dh) * (D ** -0.5)),
            "wo": _w((lambda *s: torch.randn(*s, dtype=torch.bfloat16) * 0.05)(Hq * Dh, D) * ((Hq * Dh) ** -0.5)),
        }
    _A_in = _A_setup()

    def _B_setup():
        B, Sq, D = 8, 1, 512
        Hq, Hkv, Sk, Dh = 32, 8, 8192, 128
        assert Hq % Hkv == 0, (Hq, Hkv)
        return {
            "x": _w((lambda *s: torch.randn(*s, dtype=torch.bfloat16) * 0.05)(B, Sq, D)),
            "k_cache": _w((lambda *s: torch.randn(*s, dtype=torch.bfloat16) * 6.4)(B, Hkv, Sk, Dh)),
            "v_cache": _w((lambda *s: torch.randn(*s, dtype=torch.bfloat16) * 0.05)(B, Hkv, Sk, Dh)),
            "wq": _w((lambda *s: torch.randn(*s, dtype=torch.bfloat16) * 6.4)(D, Hq * Dh) * (D ** -0.5)),
            "wo": _w((lambda *s: torch.randn(*s, dtype=torch.bfloat16) * 0.05)(Hq * Dh, D) * ((Hq * Dh) ** -0.5)),
        }
    _B_in = _B_setup()

    return {
        "A_x": _A_in["x"],
        "A_k_cache": _A_in["k_cache"],
        "A_v_cache": _A_in["v_cache"],
        "A_wq": _A_in["wq"],
        "A_wo": _A_in["wo"],
        "B_x": _B_in["x"],
        "B_k_cache": _B_in["k_cache"],
        "B_v_cache": _B_in["v_cache"],
        "B_wq": _B_in["wq"],
        "B_wo": _B_in["wo"],
        "gate_w": _w((lambda *s: torch.randn(*s, dtype=torch.bfloat16) * 0.05)(512) * 16.0),
    }

def reference(A_x, A_k_cache, A_v_cache, A_wq, A_wo, B_x, B_k_cache, B_v_cache, B_wq, B_wo, gate_w):
    def _A_ref(x, k_cache, v_cache, wq, wo):
        B, Sq, D = x.shape
        Hq, Dh = 32, 128
        Hkv, Sk = k_cache.shape[1], k_cache.shape[2]
        W = min(4096, max(256, Sk // 4))
        rep = Hq // Hkv
        q = (lambda x, *d: x.permute(*d))((x @ wq).reshape(B, Sq, Hq, Dh), 0, 2, 1, 3)
        k = (lambda x, n, axis: torch.repeat_interleave(x, n, dim=axis))(k_cache[:, :, Sk - W:, :], rep, axis=1)
        v = (lambda x, n, axis: torch.repeat_interleave(x, n, dim=axis))(v_cache[:, :, Sk - W:, :], rep, axis=1)
        scores = torch.einsum("bhqd,bhkd->bhqk", q, k) * (Dh ** -0.5)
        p = _softmax(scores, axis=-1)
        o = torch.einsum("bhqk,bhkd->bhqd", p, v)
        return (lambda x, *d: x.permute(*d))(o, 0, 2, 1, 3).reshape(B, Sq, Hq * Dh) @ wo

    def _B_ref(x, k_cache, v_cache, wq, wo):
        B, Sq, D = x.shape
        Hq, Dh = 32, 128
        Hkv, Sk = k_cache.shape[1], k_cache.shape[2]
        W = min(4096, max(256, Sk // 4))
        rep = Hq // Hkv
        q = (lambda x, *d: x.permute(*d))((x @ wq).reshape(B, Sq, Hq, Dh), 0, 2, 1, 3)
        k = (lambda x, n, axis: torch.repeat_interleave(x, n, dim=axis))(k_cache[:, :, Sk - W:, :], rep, axis=1)
        v = (lambda x, n, axis: torch.repeat_interleave(x, n, dim=axis))(v_cache[:, :, Sk - W:, :], rep, axis=1)
        scores = torch.einsum("bhqd,bhkd->bhqk", q, k) * (Dh ** -0.5)
        p = _softmax(scores, axis=-1)
        o = torch.einsum("bhqk,bhkd->bhqd", p, v)
        return (lambda x, *d: x.permute(*d))(o, 0, 2, 1, 3).reshape(B, Sq, Hq * Dh) @ wo

    x = A_x
    g = _sigmoid((x * gate_w).sum(-1, keepdims=True))
    a = _A_ref(x, A_k_cache, A_v_cache, A_wq, A_wo)
    b = _B_ref(x, B_k_cache, B_v_cache, B_wq, B_wo)
    return g * a + (1 - g) * b
```

```asm
; @launch grid=(256,1,1) block=(512,1,1) lds=57344
.amdgcn_target "amdgcn-amd-amdhsa--gfx950"
.text
.globl gated_mix__sliding_block_cached__sliding_block_cached__decode_kernel
.p2align 8
.type gated_mix__sliding_block_cached__sliding_block_cached__decode_kernel,@function
gated_mix__sliding_block_cached__sliding_block_cached__decode_kernel:

    s_cmp_ge_u32 s2, 256
    s_cbranch_scc1 L_end

    s_load_dwordx4 s[4:7], s[0:1], 8
    s_load_dwordx4 s[8:11], s[0:1], 48
    s_load_dwordx4 s[12:15], s[0:1], 24
    s_load_dwordx4 s[16:19], s[0:1], 64
    s_load_dwordx2 s[20:21], s[0:1], 0
    s_load_dwordx2 s[22:23], s[0:1], 80
    s_load_dwordx4 s[84:87], s[0:1], 88
    s_load_dwordx2 s[88:89], s[0:1], 104
    v_lshrrev_b32 v1, 6, v0
    v_and_b32 v240, 63, v0
    v_readfirstlane_b32 s3, v1
    v_and_b32 v241, 15, v240
    v_lshrrev_b32 v242, 4, v240
    s_and_b32 s76, s2, 7
    s_lshr_b32 s77, s2, 3
    s_lshr_b32 s78, s77, 4
    s_lshl_b32 s76, s76, 1
    s_add_u32 s70, s76, s78
    s_and_b32 s71, s77, 15

    s_lshr_b32 s72, s71, 1
    s_and_b32 s73, s71, 1
    s_and_b32 s74, s70, 1
    s_lshr_b32 s75, s70, 1
    v_and_b32 v5, 3, v241
    v_lshrrev_b32 v6, 2, v241
    v_lshlrev_b32 v5, 2, v5
    v_add_u32 v5, v5, v6
    v_lshlrev_b32 v5, 8, v5
    v_lshlrev_b32 v4, 4, v242
    v_add_u32 v254, v5, v4
    v_lshlrev_b32 v255, 4, v240

    s_lshl_b32 s40, s3, 15

    s_add_u32 s41, s40, 4096
    s_add_u32 s42, s40, 8192
    s_add_u32 s43, s40, 12288
    s_add_u32 s44, s40, 16384
    s_add_u32 s45, s40, 20480
    s_add_u32 s46, s40, 24576
    s_add_u32 s47, s40, 28672

    s_lshl_b32 s79, s70, 4
    s_add_u32 s79, s79, s71
    s_lshl_b32 s79, s79, 12
    v_mov_b32 v248, 0
    v_mov_b32 v249, 0
    s_cmp_lg_u32 s3, 0
    s_cbranch_scc1 L_noinit
    ds_write_b64 v248, v[248:249] offset:0
    ds_write_b64 v248, v[248:249] offset:8
L_noinit:
    s_waitcnt lgkmcnt(0)

    s_cmp_eq_u32 s74, 1
    s_cselect_b32 s4, s8, s4
    s_cselect_b32 s5, s9, s5
    s_cselect_b32 s6, s10, s6
    s_cselect_b32 s7, s11, s7
    s_cselect_b32 s12, s16, s12
    s_cselect_b32 s13, s17, s13
    s_cselect_b32 s14, s18, s14
    s_cselect_b32 s15, s19, s15
    s_lshl_b32 s76, s72, 24
    s_lshl_b32 s77, s75, 21
    s_add_u32 s76, s76, s77
    s_lshl_b32 s77, s73, 18
    s_add_u32 s76, s76, s77
    s_add_u32 s76, s76, 1572864
    s_add_u32 s24, s4, s76
    s_addc_u32 s25, s5, 0
    s_mov_b32 s26, 262144
    s_mov_b32 s27, 0x00020000
    s_add_u32 s28, s6, s76
    s_addc_u32 s29, s7, 0
    s_mov_b32 s30, 262144
    s_mov_b32 s31, 0x00020000
    s_mov_b32 s32, s88
    s_mov_b32 s33, s89
    s_mov_b32 s34, 5242880
    s_mov_b32 s35, 0x00020000
    s_mov_b32 s48, s86
    s_mov_b32 s49, s87
    s_mov_b32 s50, 256
    s_mov_b32 s51, 0x00020000
    s_lshr_b32 s76, s71, 2
    s_and_b32 s77, s71, 3
    s_lshl_b32 s78, s75, 2
    s_add_u32 s78, s78, s76
    s_lshl_b32 s80, s78, 17
    s_lshl_b32 s81, s77, 8
    s_add_u32 s80, s80, s81
    s_add_u32 s80, s14, s80
    s_addc_u32 s81, s15, 0
    s_mov_b32 s82, 130304
    s_mov_b32 s83, 0x00020000
    s_lshl_b32 s36, s78, 8
    s_lshl_b32 s37, s77, 6
    s_add_u32 s36, s36, s37
    s_add_u32 s36, s12, s36
    s_addc_u32 s37, s13, 0
    s_mov_b32 s38, 4186176
    s_mov_b32 s39, 0x00020000
    s_mov_b32 s52, s20
    s_mov_b32 s53, s21
    s_mov_b32 s54, 8192
    s_mov_b32 s55, 0x00020000
    v_mov_b32 v244, 0
    s_mov_b32 s76, 524288
    buffer_load_dword v243, v244, s[32:35], s76 offen sc1
    v_lshrrev_b32 v245, 3, v241
    v_lshlrev_b32 v246, 18, v245
    v_lshlrev_b32 v247, 16, v242
    v_add_u32 v246, v246, v247
    v_and_b32 v247, 7, v241
    v_lshlrev_b32 v248, 3, v247
    v_add_u32 v246, v246, v248
    s_lshl_b32 s76, s3, 19

    buffer_load_dwordx2 v[192:193], v246, s[36:39], s76 offen
    s_add_u32 s76, s76, 8192
    buffer_load_dwordx2 v[194:195], v246, s[36:39], s76 offen
    s_add_u32 s76, s76, 8192
    buffer_load_dwordx2 v[196:197], v246, s[36:39], s76 offen
    s_add_u32 s76, s76, 8192
    buffer_load_dwordx2 v[198:199], v246, s[36:39], s76 offen
    s_add_u32 s76, s76, 8192
    buffer_load_dwordx2 v[200:201], v246, s[36:39], s76 offen
    s_add_u32 s76, s76, 8192
    buffer_load_dwordx2 v[202:203], v246, s[36:39], s76 offen
    s_add_u32 s76, s76, 8192
    buffer_load_dwordx2 v[204:205], v246, s[36:39], s76 offen
    s_add_u32 s76, s76, 8192
    buffer_load_dwordx2 v[206:207], v246, s[36:39], s76 offen

    v_lshlrev_b32 v248, 10, v247
    v_lshlrev_b32 v249, 6, v245
    v_add_u32 v248, v248, v249
    v_lshlrev_b32 v249, 4, v242
    v_add_u32 v248, v248, v249
    s_lshl_b32 s76, s3, 7
    buffer_load_dwordx4 v[208:211], v248, s[52:55], s76 offen
    s_cmp_lg_u32 s3, 0
    s_cbranch_scc1 L_nogate
    s_setprio 3
    s_mov_b32 s56, s22
    s_mov_b32 s57, s23
    s_mov_b32 s58, 1024
    s_mov_b32 s59, 0x00020000
    s_lshr_b32 s76, s2, 5
    s_lshl_b32 s76, s76, 10
    buffer_load_dwordx4 v[224:227], v255, s[52:55], s76 offen
    buffer_load_dwordx4 v[228:231], v255, s[56:59], 0 offen
L_nogate:

    s_barrier
    buffer_load_dwordx4 v[0:3], v254, s[24:27], s40 offen offset:0 nt
    buffer_load_dwordx4 v[4:7], v254, s[24:27], s40 offen offset:64 nt
    buffer_load_dwordx4 v[8:11], v254, s[24:27], s40 offen offset:128 nt
    buffer_load_dwordx4 v[12:15], v254, s[24:27], s40 offen offset:192 nt
    buffer_load_dwordx4 v[16:19], v254, s[24:27], s41 offen offset:0 nt
    buffer_load_dwordx4 v[20:23], v254, s[24:27], s41 offen offset:64 nt
    buffer_load_dwordx4 v[24:27], v254, s[24:27], s41 offen offset:128 nt
    buffer_load_dwordx4 v[28:31], v254, s[24:27], s41 offen offset:192 nt
    s_barrier

    s_lshl_b32 s76, s3, 1
    v_add_u32 v245, s76, v245
    v_mul_u32_u24 v245, 1152, v245
    v_and_b32 v246, 1, v242
    v_lshlrev_b32 v246, 9, v246
    v_add_u32 v245, v245, v246
    v_lshlrev_b32 v247, 4, v247
    v_add_u32 v245, v245, v247
    v_add_u32 v245, 4096, v245
    s_mov_b32 s76, 0x05040100
    s_mov_b32 s77, 0x07060302

    s_waitcnt vmcnt(8)
    v_perm_b32 v144, v194, v192, s76
    v_perm_b32 v145, v198, v196, s76
    v_perm_b32 v146, v202, v200, s76
    v_perm_b32 v147, v206, v204, s76
    v_perm_b32 v148, v194, v192, s77
    v_perm_b32 v149, v198, v196, s77
    v_perm_b32 v150, v202, v200, s77
    v_perm_b32 v151, v206, v204, s77
    v_perm_b32 v152, v195, v193, s76
    v_perm_b32 v153, v199, v197, s76
    v_perm_b32 v154, v203, v201, s76
    v_perm_b32 v155, v207, v205, s76
    v_perm_b32 v156, v195, v193, s77
    v_perm_b32 v157, v199, v197, s77
    v_perm_b32 v158, v203, v201, s77
    v_perm_b32 v159, v207, v205, s77
    v_mfma_f32_16x16x32_bf16 v[128:131], v[208:211], v[144:147], 0
    v_mfma_f32_16x16x32_bf16 v[132:135], v[208:211], v[148:151], 0
    v_mfma_f32_16x16x32_bf16 v[136:139], v[208:211], v[152:155], 0
    v_mfma_f32_16x16x32_bf16 v[140:143], v[208:211], v[156:159], 0

    v_readfirstlane_b32 s101, v243
    s_mul_i32 s101, s101, 0x9E3779B1
    s_add_u32 s101, s101, 0x7F4A7C15
    s_mov_b32 exec_lo, 0x00ff00ff
    s_mov_b32 exec_hi, 0xff00ff00
    s_nop 4

    ds_write2_b32 v245, v128, v132 offset0:0 offset1:1
    ds_write2_b32 v245, v136, v140 offset0:2 offset1:3
    ds_write2_b32 v245, v129, v133 offset0:32 offset1:33
    ds_write2_b32 v245, v137, v141 offset0:34 offset1:35
    ds_write2_b32 v245, v130, v134 offset0:64 offset1:65
    ds_write2_b32 v245, v138, v142 offset0:66 offset1:67
    ds_write2_b32 v245, v131, v135 offset0:96 offset1:97
    ds_write2_b32 v245, v139, v143 offset0:98 offset1:99

    v_mov_b32 v243, 1
    v_mov_b32 v244, 0
    s_mov_b64 exec, 1
    s_waitcnt lgkmcnt(0)
    ds_add_u32 v244, v243 offset:4
    s_mov_b64 exec, -1

    s_cmp_lg_u32 s3, 0
    s_cbranch_scc1 L_stream
    s_mov_b32 s78, 400000
L_cpoll:
    ds_read_b32 v243, v244 offset:4
    s_waitcnt lgkmcnt(0)
    v_readfirstlane_b32 s76, v243
    s_cmp_ge_u32 s76, 8
    s_cbranch_scc1 L_cgo
    s_sub_u32 s78, s78, 1
    s_cmp_eq_u32 s78, 0
    s_cbranch_scc1 L_cgo
    s_sleep 1
    s_branch L_cpoll
L_cgo:

    ds_read_b128 v[128:131], v255 offset:4096
    ds_read_b128 v[132:135], v255 offset:5248
    ds_read_b128 v[136:139], v255 offset:6400
    ds_read_b128 v[140:143], v255 offset:7552
    ds_read_b128 v[144:147], v255 offset:8704
    ds_read_b128 v[148:151], v255 offset:9856
    ds_read_b128 v[152:155], v255 offset:11008
    ds_read_b128 v[156:159], v255 offset:12160
    ds_read_b128 v[160:163], v255 offset:13312
    ds_read_b128 v[164:167], v255 offset:14464
    ds_read_b128 v[168:171], v255 offset:15616
    ds_read_b128 v[172:175], v255 offset:16768
    ds_read_b128 v[176:179], v255 offset:17920
    ds_read_b128 v[180:183], v255 offset:19072
    ds_read_b128 v[184:187], v255 offset:20224
    ds_read_b128 v[188:191], v255 offset:21376

    s_lshr_b32 s76, s79, 2
    s_add_u32 s76, s76, 0
    v_mov_b32 v233, s101
    v_mov_b32 v235, s101

    s_waitcnt lgkmcnt(8)
    v_add_f32 v128, v128, v144
    v_add_f32 v129, v129, v145
    v_add_f32 v130, v130, v146
    v_add_f32 v131, v131, v147
    v_add_f32 v132, v132, v148
    v_add_f32 v133, v133, v149
    v_add_f32 v134, v134, v150
    v_add_f32 v135, v135, v151
    v_add_f32 v136, v136, v152
    v_add_f32 v137, v137, v153
    v_add_f32 v138, v138, v154
    v_add_f32 v139, v139, v155
    v_add_f32 v140, v140, v156
    v_add_f32 v141, v141, v157
    v_add_f32 v142, v142, v158
    v_add_f32 v143, v143, v159
    s_waitcnt lgkmcnt(0)
    v_add_f32 v160, v160, v176
    v_add_f32 v161, v161, v177
    v_add_f32 v162, v162, v178
    v_add_f32 v163, v163, v179
    v_add_f32 v164, v164, v180
    v_add_f32 v165, v165, v181
    v_add_f32 v166, v166, v182
    v_add_f32 v167, v167, v183
    v_add_f32 v168, v168, v184
    v_add_f32 v169, v169, v185
    v_add_f32 v170, v170, v186
    v_add_f32 v171, v171, v187
    v_add_f32 v172, v172, v188
    v_add_f32 v173, v173, v189
    v_add_f32 v174, v174, v190
    v_add_f32 v175, v175, v191
    v_add_f32 v128, v128, v160
    v_add_f32 v129, v129, v161
    v_add_f32 v130, v130, v162
    v_add_f32 v131, v131, v163
    v_add_f32 v132, v132, v164
    v_add_f32 v133, v133, v165
    v_add_f32 v134, v134, v166
    v_add_f32 v135, v135, v167
    v_add_f32 v136, v136, v168
    v_add_f32 v137, v137, v169
    v_add_f32 v138, v138, v170
    v_add_f32 v139, v139, v171
    v_add_f32 v140, v140, v172
    v_add_f32 v141, v141, v173
    v_add_f32 v142, v142, v174
    v_add_f32 v143, v143, v175
    v_add_f32 v128, v128, v136
    v_add_f32 v129, v129, v137
    v_add_f32 v130, v130, v138
    v_add_f32 v131, v131, v139
    v_add_f32 v132, v132, v140
    v_add_f32 v133, v133, v141
    v_add_f32 v134, v134, v142
    v_add_f32 v135, v135, v143
    v_add_f32 v128, v128, v132
    v_add_f32 v129, v129, v133
    v_add_f32 v130, v130, v134
    v_add_f32 v131, v131, v135

    v_cvt_pk_bf16_f32 v232, v128, v129
    v_cvt_pk_bf16_f32 v234, v130, v131
    buffer_store_dwordx4 v[232:235], v255, s[32:35], s76 offen sc1

    v_lshrrev_b32 v245, 3, v240
    v_and_b32 v246, 7, v240
    v_lshlrev_b32 v247, 10, v245
    v_lshlrev_b32 v248, 4, v246
    v_add_u32 v247, v247, v248
    s_lshl_b32 s4, s70, 14
    s_lshl_b32 s5, s72, 7
    s_add_u32 s4, s4, s5
    s_add_u32 s4, s4, 0
    s_add_u32 s5, s4, 8192
    buffer_load_dwordx4 v[160:163], v247, s[32:35], s4 offen sc1
    buffer_load_dwordx4 v[164:167], v247, s[32:35], s5 offen sc1

    v_lshlrev_b32 v136, 16, v224
    v_and_b32 v137, 0xffff0000, v224
    v_lshlrev_b32 v138, 16, v228
    v_and_b32 v139, 0xffff0000, v228
    v_mul_f32 v140, v136, v138
    v_fma_f32 v140, v137, v139, v140

    v_lshlrev_b32 v136, 16, v225
    v_and_b32 v137, 0xffff0000, v225
    v_lshlrev_b32 v138, 16, v229
    v_and_b32 v139, 0xffff0000, v229
    v_fma_f32 v140, v136, v138, v140
    v_fma_f32 v140, v137, v139, v140

    v_lshlrev_b32 v136, 16, v226
    v_and_b32 v137, 0xffff0000, v226
    v_lshlrev_b32 v138, 16, v230
    v_and_b32 v139, 0xffff0000, v230
    v_fma_f32 v140, v136, v138, v140
    v_fma_f32 v140, v137, v139, v140

    v_lshlrev_b32 v136, 16, v227
    v_and_b32 v137, 0xffff0000, v227
    v_lshlrev_b32 v138, 16, v231
    v_and_b32 v139, 0xffff0000, v231
    v_fma_f32 v140, v136, v138, v140
    v_fma_f32 v140, v137, v139, v140

    s_nop 1
    v_add_f32_dpp v140, v140, v140 row_ror:8 row_mask:0xf bank_mask:0xf
    s_nop 1
    v_add_f32_dpp v140, v140, v140 row_ror:4 row_mask:0xf bank_mask:0xf
    s_nop 1
    v_add_f32_dpp v140, v140, v140 row_ror:2 row_mask:0xf bank_mask:0xf
    s_nop 1
    v_add_f32_dpp v140, v140, v140 row_ror:1 row_mask:0xf bank_mask:0xf
    s_nop 1
    v_mov_b32 v141, v140
    s_nop 1
    v_permlane16_swap_b32 v141, v140
    s_nop 1
    v_add_f32 v140, v140, v141
    v_mov_b32 v141, v140
    s_nop 1
    v_permlane32_swap_b32 v141, v140
    s_nop 1
    v_add_f32 v140, v140, v141
    s_mov_b32 s76, 1069066811
    v_mul_f32 v140, s76, v140
    v_sub_f32 v140, 0, v140
    v_exp_f32 v140, v140
    s_nop 0
    v_add_f32 v140, 1.0, v140
    v_rcp_f32 v140, v140
    v_lshrrev_b32 v248, 5, v240
    v_mul_u32_u24 v248, 272, v248
    v_and_b32 v245, 3, v245
    v_lshlrev_b32 v245, 6, v245
    v_add_u32 v248, v248, v245
    v_lshlrev_b32 v246, 3, v246
    v_add_u32 v248, v248, v246
    v_readfirstlane_b32 s100, v140
    s_mov_b32 s78, 4000
L_qpoll:
    s_waitcnt vmcnt(0)

    v_cmp_ne_u32 vcc, s101, v161
    v_cmp_ne_u32 s[6:7], s101, v163
    v_cmp_ne_u32 s[8:9], s101, v165
    v_cmp_ne_u32 s[10:11], s101, v167
    s_nop 1
    s_or_b64 vcc, vcc, s[6:7]
    s_or_b64 s[8:9], s[8:9], s[10:11]
    s_or_b64 vcc, vcc, s[8:9]
    s_cbranch_vccz L_qgo
    s_sub_u32 s78, s78, 1
    s_cmp_eq_u32 s78, 0
    s_cbranch_scc1 L_qgo
    s_sleep 1
    buffer_load_dwordx4 v[160:163], v247, s[32:35], s4 offen sc1
    buffer_load_dwordx4 v[164:167], v247, s[32:35], s5 offen sc1
    s_branch L_qpoll
L_qgo:
    ds_write2_b32 v248, v160, v162 offset0:4 offset1:5
    ds_write2_b32 v248, v164, v166 offset0:140 offset1:141
    v_mov_b32 v243, 1
    v_mov_b32 v244, 0
    s_waitcnt lgkmcnt(0)
    ds_write_b32 v244, v243

    s_setprio 0
    s_branch L_W0
L_stream:

    v_mov_b32 v244, 0
    s_branch L_U0

    ds_read_b32 v243, v244
    s_waitcnt lgkmcnt(0)
    v_readfirstlane_b32 s76, v243
    s_cmp_lg_u32 s76, 0
    s_cbranch_scc1 L_U0

    s_waitcnt vmcnt(7)
    buffer_load_dwordx4 v[32:35], v254, s[24:27], s42 offen offset:0 nt
    s_waitcnt vmcnt(7)
    buffer_load_dwordx4 v[36:39], v254, s[24:27], s42 offen offset:64 nt
    s_waitcnt vmcnt(7)
    buffer_load_dwordx4 v[40:43], v254, s[24:27], s42 offen offset:128 nt
    s_waitcnt vmcnt(7)
    buffer_load_dwordx4 v[44:47], v254, s[24:27], s42 offen offset:192 nt
    s_waitcnt vmcnt(7)
    buffer_load_dwordx4 v[48:51], v254, s[24:27], s43 offen offset:0 nt
    s_waitcnt vmcnt(7)
    buffer_load_dwordx4 v[52:55], v254, s[24:27], s43 offen offset:64 nt
    s_waitcnt vmcnt(7)
    buffer_load_dwordx4 v[56:59], v254, s[24:27], s43 offen offset:128 nt
    s_waitcnt vmcnt(7)
    buffer_load_dwordx4 v[60:63], v254, s[24:27], s43 offen offset:192 nt

    ds_read_b32 v243, v244
    s_waitcnt lgkmcnt(0)
    v_readfirstlane_b32 s76, v243
    s_cmp_lg_u32 s76, 0
    s_cbranch_scc1 L_U1

    s_waitcnt vmcnt(7)
    buffer_load_dwordx4 v[64:67], v254, s[24:27], s44 offen offset:0 nt
    s_waitcnt vmcnt(7)
    buffer_load_dwordx4 v[68:71], v254, s[24:27], s44 offen offset:64 nt
    s_waitcnt vmcnt(7)
    buffer_load_dwordx4 v[72:75], v254, s[24:27], s44 offen offset:128 nt
    s_waitcnt vmcnt(7)
    buffer_load_dwordx4 v[76:79], v254, s[24:27], s44 offen offset:192 nt
    s_waitcnt vmcnt(7)
    buffer_load_dwordx4 v[80:83], v254, s[24:27], s45 offen offset:0 nt
    s_waitcnt vmcnt(7)
    buffer_load_dwordx4 v[84:87], v254, s[24:27], s45 offen offset:64 nt
    s_waitcnt vmcnt(7)
    buffer_load_dwordx4 v[88:91], v254, s[24:27], s45 offen offset:128 nt
    s_waitcnt vmcnt(7)
    buffer_load_dwordx4 v[92:95], v254, s[24:27], s45 offen offset:192 nt

    ds_read_b32 v243, v244
    s_waitcnt lgkmcnt(0)
    v_readfirstlane_b32 s76, v243
    s_cmp_lg_u32 s76, 0
    s_cbranch_scc1 L_U2

    s_waitcnt vmcnt(7)
    buffer_load_dwordx4 v[96:99], v254, s[24:27], s46 offen offset:0 nt
    s_waitcnt vmcnt(7)
    buffer_load_dwordx4 v[100:103], v254, s[24:27], s46 offen offset:64 nt
    s_waitcnt vmcnt(7)
    buffer_load_dwordx4 v[104:107], v254, s[24:27], s46 offen offset:128 nt
    s_waitcnt vmcnt(7)
    buffer_load_dwordx4 v[108:111], v254, s[24:27], s46 offen offset:192 nt
    s_waitcnt vmcnt(7)
    buffer_load_dwordx4 v[112:115], v254, s[24:27], s47 offen offset:0 nt
    s_waitcnt vmcnt(7)
    buffer_load_dwordx4 v[116:119], v254, s[24:27], s47 offen offset:64 nt
    s_waitcnt vmcnt(7)
    buffer_load_dwordx4 v[120:123], v254, s[24:27], s47 offen offset:128 nt
    s_waitcnt vmcnt(7)
    buffer_load_dwordx4 v[124:127], v254, s[24:27], s47 offen offset:192 nt

    ds_read_b32 v243, v244
    s_waitcnt lgkmcnt(0)
    v_readfirstlane_b32 s76, v243
    s_cmp_lg_u32 s76, 0
    s_cbranch_scc1 L_U3

    s_waitcnt vmcnt(7)
    buffer_load_dwordx4 v[128:131], v255, s[28:31], s40 offen offset:0 nt
    s_waitcnt vmcnt(7)
    buffer_load_dwordx4 v[132:135], v255, s[28:31], s40 offen offset:1024 nt
    s_waitcnt vmcnt(7)
    buffer_load_dwordx4 v[136:139], v255, s[28:31], s40 offen offset:2048 nt
    s_waitcnt vmcnt(7)
    buffer_load_dwordx4 v[140:143], v255, s[28:31], s40 offen offset:3072 nt
    s_waitcnt vmcnt(7)
    buffer_load_dwordx4 v[144:147], v255, s[28:31], s41 offen offset:0 nt
    s_waitcnt vmcnt(7)
    buffer_load_dwordx4 v[148:151], v255, s[28:31], s41 offen offset:1024 nt
    s_waitcnt vmcnt(7)
    buffer_load_dwordx4 v[152:155], v255, s[28:31], s41 offen offset:2048 nt
    s_waitcnt vmcnt(7)
    buffer_load_dwordx4 v[156:159], v255, s[28:31], s41 offen offset:3072 nt

    ds_read_b32 v243, v244
    s_waitcnt lgkmcnt(0)
    v_readfirstlane_b32 s76, v243
    s_cmp_lg_u32 s76, 0
    s_cbranch_scc1 L_U4

    s_waitcnt vmcnt(7)
    buffer_load_dwordx4 v[160:163], v255, s[28:31], s42 offen offset:0 nt
    s_waitcnt vmcnt(7)
    buffer_load_dwordx4 v[164:167], v255, s[28:31], s42 offen offset:1024 nt
    s_waitcnt vmcnt(7)
    buffer_load_dwordx4 v[168:171], v255, s[28:31], s42 offen offset:2048 nt
    s_waitcnt vmcnt(7)
    buffer_load_dwordx4 v[172:175], v255, s[28:31], s42 offen offset:3072 nt
    s_waitcnt vmcnt(7)
    buffer_load_dwordx4 v[176:179], v255, s[28:31], s43 offen offset:0 nt
    s_waitcnt vmcnt(7)
    buffer_load_dwordx4 v[180:183], v255, s[28:31], s43 offen offset:1024 nt
    s_waitcnt vmcnt(7)
    buffer_load_dwordx4 v[184:187], v255, s[28:31], s43 offen offset:2048 nt
    s_waitcnt vmcnt(7)
    buffer_load_dwordx4 v[188:191], v255, s[28:31], s43 offen offset:3072 nt
    s_branch L_Uend
L_U0:
    buffer_load_dwordx4 v[32:35], v254, s[24:27], s42 offen offset:0 nt
    buffer_load_dwordx4 v[36:39], v254, s[24:27], s42 offen offset:64 nt
    buffer_load_dwordx4 v[40:43], v254, s[24:27], s42 offen offset:128 nt
    buffer_load_dwordx4 v[44:47], v254, s[24:27], s42 offen offset:192 nt
    buffer_load_dwordx4 v[48:51], v254, s[24:27], s43 offen offset:0 nt
    buffer_load_dwordx4 v[52:55], v254, s[24:27], s43 offen offset:64 nt
    buffer_load_dwordx4 v[56:59], v254, s[24:27], s43 offen offset:128 nt
    buffer_load_dwordx4 v[60:63], v254, s[24:27], s43 offen offset:192 nt
L_U1:
    buffer_load_dwordx4 v[64:67], v254, s[24:27], s44 offen offset:0 nt
    buffer_load_dwordx4 v[68:71], v254, s[24:27], s44 offen offset:64 nt
    buffer_load_dwordx4 v[72:75], v254, s[24:27], s44 offen offset:128 nt
    buffer_load_dwordx4 v[76:79], v254, s[24:27], s44 offen offset:192 nt
    buffer_load_dwordx4 v[80:83], v254, s[24:27], s45 offen offset:0 nt
    buffer_load_dwordx4 v[84:87], v254, s[24:27], s45 offen offset:64 nt
    buffer_load_dwordx4 v[88:91], v254, s[24:27], s45 offen offset:128 nt
    buffer_load_dwordx4 v[92:95], v254, s[24:27], s45 offen offset:192 nt
L_U2:
    buffer_load_dwordx4 v[96:99], v254, s[24:27], s46 offen offset:0 nt
    buffer_load_dwordx4 v[100:103], v254, s[24:27], s46 offen offset:64 nt
    buffer_load_dwordx4 v[104:107], v254, s[24:27], s46 offen offset:128 nt
    buffer_load_dwordx4 v[108:111], v254, s[24:27], s46 offen offset:192 nt
    buffer_load_dwordx4 v[112:115], v254, s[24:27], s47 offen offset:0 nt
    buffer_load_dwordx4 v[116:119], v254, s[24:27], s47 offen offset:64 nt
    buffer_load_dwordx4 v[120:123], v254, s[24:27], s47 offen offset:128 nt
    buffer_load_dwordx4 v[124:127], v254, s[24:27], s47 offen offset:192 nt
L_U3:
    buffer_load_dwordx4 v[128:131], v255, s[28:31], s40 offen offset:0 nt
    buffer_load_dwordx4 v[132:135], v255, s[28:31], s40 offen offset:1024 nt
    buffer_load_dwordx4 v[136:139], v255, s[28:31], s40 offen offset:2048 nt
    buffer_load_dwordx4 v[140:143], v255, s[28:31], s40 offen offset:3072 nt
    buffer_load_dwordx4 v[144:147], v255, s[28:31], s41 offen offset:0 nt
    buffer_load_dwordx4 v[148:151], v255, s[28:31], s41 offen offset:1024 nt
    buffer_load_dwordx4 v[152:155], v255, s[28:31], s41 offen offset:2048 nt
    buffer_load_dwordx4 v[156:159], v255, s[28:31], s41 offen offset:3072 nt
L_U4:
    buffer_load_dwordx4 v[160:163], v255, s[28:31], s42 offen offset:0 nt
    buffer_load_dwordx4 v[164:167], v255, s[28:31], s42 offen offset:1024 nt
    buffer_load_dwordx4 v[168:171], v255, s[28:31], s42 offen offset:2048 nt
    buffer_load_dwordx4 v[172:175], v255, s[28:31], s42 offen offset:3072 nt
    buffer_load_dwordx4 v[176:179], v255, s[28:31], s43 offen offset:0 nt
    buffer_load_dwordx4 v[180:183], v255, s[28:31], s43 offen offset:1024 nt
    buffer_load_dwordx4 v[184:187], v255, s[28:31], s43 offen offset:2048 nt
    buffer_load_dwordx4 v[188:191], v255, s[28:31], s43 offen offset:3072 nt
    s_branch L_Uend
L_W0:
    buffer_load_dwordx4 v[32:35], v254, s[24:27], s42 offen offset:0 nt
    buffer_load_dwordx4 v[36:39], v254, s[24:27], s42 offen offset:64 nt
    buffer_load_dwordx4 v[40:43], v254, s[24:27], s42 offen offset:128 nt
    buffer_load_dwordx4 v[44:47], v254, s[24:27], s42 offen offset:192 nt
    buffer_load_dwordx4 v[48:51], v254, s[24:27], s43 offen offset:0 nt
    buffer_load_dwordx4 v[52:55], v254, s[24:27], s43 offen offset:64 nt
    buffer_load_dwordx4 v[56:59], v254, s[24:27], s43 offen offset:128 nt
    buffer_load_dwordx4 v[60:63], v254, s[24:27], s43 offen offset:192 nt
    buffer_load_dwordx4 v[64:67], v254, s[24:27], s44 offen offset:0 nt
    buffer_load_dwordx4 v[68:71], v254, s[24:27], s44 offen offset:64 nt
    buffer_load_dwordx4 v[72:75], v254, s[24:27], s44 offen offset:128 nt
    buffer_load_dwordx4 v[76:79], v254, s[24:27], s44 offen offset:192 nt
    buffer_load_dwordx4 v[80:83], v254, s[24:27], s45 offen offset:0 nt
    buffer_load_dwordx4 v[84:87], v254, s[24:27], s45 offen offset:64 nt
    buffer_load_dwordx4 v[88:91], v254, s[24:27], s45 offen offset:128 nt
    buffer_load_dwordx4 v[92:95], v254, s[24:27], s45 offen offset:192 nt
    buffer_load_dwordx4 v[96:99], v254, s[24:27], s46 offen offset:0 nt
    buffer_load_dwordx4 v[100:103], v254, s[24:27], s46 offen offset:64 nt
    buffer_load_dwordx4 v[104:107], v254, s[24:27], s46 offen offset:128 nt
    buffer_load_dwordx4 v[108:111], v254, s[24:27], s46 offen offset:192 nt
    buffer_load_dwordx4 v[112:115], v254, s[24:27], s47 offen offset:0 nt
    buffer_load_dwordx4 v[116:119], v254, s[24:27], s47 offen offset:64 nt
    buffer_load_dwordx4 v[120:123], v254, s[24:27], s47 offen offset:128 nt
    buffer_load_dwordx4 v[124:127], v254, s[24:27], s47 offen offset:192 nt
    buffer_load_dwordx4 v[128:131], v255, s[28:31], s40 offen offset:0 nt
    buffer_load_dwordx4 v[132:135], v255, s[28:31], s40 offen offset:1024 nt
    buffer_load_dwordx4 v[136:139], v255, s[28:31], s40 offen offset:2048 nt
    buffer_load_dwordx4 v[140:143], v255, s[28:31], s40 offen offset:3072 nt
    buffer_load_dwordx4 v[144:147], v255, s[28:31], s41 offen offset:0 nt
    buffer_load_dwordx4 v[148:151], v255, s[28:31], s41 offen offset:1024 nt
    buffer_load_dwordx4 v[152:155], v255, s[28:31], s41 offen offset:2048 nt
    buffer_load_dwordx4 v[156:159], v255, s[28:31], s41 offen offset:3072 nt
    buffer_load_dwordx4 v[160:163], v255, s[28:31], s42 offen offset:0 nt
    buffer_load_dwordx4 v[164:167], v255, s[28:31], s42 offen offset:1024 nt
    buffer_load_dwordx4 v[168:171], v255, s[28:31], s42 offen offset:2048 nt
    buffer_load_dwordx4 v[172:175], v255, s[28:31], s42 offen offset:3072 nt
    buffer_load_dwordx4 v[176:179], v255, s[28:31], s43 offen offset:0 nt
    buffer_load_dwordx4 v[180:183], v255, s[28:31], s43 offen offset:1024 nt
    buffer_load_dwordx4 v[184:187], v255, s[28:31], s43 offen offset:2048 nt
    buffer_load_dwordx4 v[188:191], v255, s[28:31], s43 offen offset:3072 nt
L_Uend:

    v_mov_b32 v244, 0
    s_mov_b32 s78, 400000
L_fpoll:
    ds_read_b32 v243, v244
    s_waitcnt lgkmcnt(0)
    v_readfirstlane_b32 s76, v243
    s_cmp_lg_u32 s76, 0
    s_cbranch_scc1 L_fgo
    s_sub_u32 s78, s78, 1
    s_cmp_eq_u32 s78, 0
    s_cbranch_scc1 L_fgo
    s_sleep 2
    s_branch L_fpoll
L_fgo:
    v_lshrrev_b32 v243, 2, v241
    v_mul_u32_u24 v243, 272, v243
    v_lshlrev_b32 v244, 4, v242
    v_add_u32 v243, v243, v244

    ds_read_b128 v[224:227], v243 offset:16
    ds_read_b128 v[228:231], v243 offset:80
    ds_read_b128 v[232:235], v243 offset:144
    ds_read_b128 v[236:239], v243 offset:208

    v_mov_b32 v248, 0x3f803f80
    v_mov_b32 v249, 0x3f803f80
    v_mov_b32 v250, 0x3f803f80
    v_mov_b32 v251, 0x3f803f80

    s_waitcnt vmcnt(32) lgkmcnt(0)
    v_mfma_f32_16x16x32_bf16 v[192:195], v[0:3], v[224:227], 0
    v_mfma_f32_16x16x32_bf16 v[196:199], v[16:19], v[224:227], 0
    v_mfma_f32_16x16x32_bf16 v[200:203], v[32:35], v[224:227], 0
    v_mfma_f32_16x16x32_bf16 v[204:207], v[48:51], v[224:227], 0
    v_mfma_f32_16x16x32_bf16 v[192:195], v[4:7], v[228:231], v[192:195]
    v_mfma_f32_16x16x32_bf16 v[196:199], v[20:23], v[228:231], v[196:199]
    v_mfma_f32_16x16x32_bf16 v[200:203], v[36:39], v[228:231], v[200:203]
    v_mfma_f32_16x16x32_bf16 v[204:207], v[52:55], v[228:231], v[204:207]
    v_mfma_f32_16x16x32_bf16 v[192:195], v[8:11], v[232:235], v[192:195]
    v_mfma_f32_16x16x32_bf16 v[196:199], v[24:27], v[232:235], v[196:199]
    v_mfma_f32_16x16x32_bf16 v[200:203], v[40:43], v[232:235], v[200:203]
    v_mfma_f32_16x16x32_bf16 v[204:207], v[56:59], v[232:235], v[204:207]
    v_mfma_f32_16x16x32_bf16 v[192:195], v[12:15], v[236:239], v[192:195]
    v_mfma_f32_16x16x32_bf16 v[196:199], v[28:31], v[236:239], v[196:199]
    v_mfma_f32_16x16x32_bf16 v[200:203], v[44:47], v[236:239], v[200:203]
    v_mfma_f32_16x16x32_bf16 v[204:207], v[60:63], v[236:239], v[204:207]
    buffer_load_dwordx4 v[0:3], v255, s[28:31], s44 offen offset:0 nt
    buffer_load_dwordx4 v[4:7], v255, s[28:31], s44 offen offset:1024 nt
    buffer_load_dwordx4 v[8:11], v255, s[28:31], s44 offen offset:2048 nt
    buffer_load_dwordx4 v[12:15], v255, s[28:31], s44 offen offset:3072 nt
    buffer_load_dwordx4 v[16:19], v255, s[28:31], s45 offen offset:0 nt
    buffer_load_dwordx4 v[20:23], v255, s[28:31], s45 offen offset:1024 nt
    buffer_load_dwordx4 v[24:27], v255, s[28:31], s45 offen offset:2048 nt
    buffer_load_dwordx4 v[28:31], v255, s[28:31], s45 offen offset:3072 nt
    buffer_load_dwordx4 v[32:35], v255, s[28:31], s46 offen offset:0 nt
    buffer_load_dwordx4 v[36:39], v255, s[28:31], s46 offen offset:1024 nt
    buffer_load_dwordx4 v[40:43], v255, s[28:31], s46 offen offset:2048 nt
    buffer_load_dwordx4 v[44:47], v255, s[28:31], s46 offen offset:3072 nt
    buffer_load_dwordx4 v[48:51], v255, s[28:31], s47 offen offset:0 nt
    buffer_load_dwordx4 v[52:55], v255, s[28:31], s47 offen offset:1024 nt
    buffer_load_dwordx4 v[56:59], v255, s[28:31], s47 offen offset:2048 nt
    buffer_load_dwordx4 v[60:63], v255, s[28:31], s47 offen offset:3072 nt
    s_waitcnt vmcnt(32)
    v_mfma_f32_16x16x32_bf16 v[208:211], v[64:67], v[224:227], 0
    v_mfma_f32_16x16x32_bf16 v[212:215], v[80:83], v[224:227], 0
    v_mfma_f32_16x16x32_bf16 v[216:219], v[96:99], v[224:227], 0
    v_mfma_f32_16x16x32_bf16 v[220:223], v[112:115], v[224:227], 0
    v_mfma_f32_16x16x32_bf16 v[208:211], v[68:71], v[228:231], v[208:211]
    v_mfma_f32_16x16x32_bf16 v[212:215], v[84:87], v[228:231], v[212:215]
    v_mfma_f32_16x16x32_bf16 v[216:219], v[100:103], v[228:231], v[216:219]
    v_mfma_f32_16x16x32_bf16 v[220:223], v[116:119], v[228:231], v[220:223]
    v_mfma_f32_16x16x32_bf16 v[208:211], v[72:75], v[232:235], v[208:211]
    v_mfma_f32_16x16x32_bf16 v[212:215], v[88:91], v[232:235], v[212:215]
    v_mfma_f32_16x16x32_bf16 v[216:219], v[104:107], v[232:235], v[216:219]
    v_mfma_f32_16x16x32_bf16 v[220:223], v[120:123], v[232:235], v[220:223]
    v_mfma_f32_16x16x32_bf16 v[208:211], v[76:79], v[236:239], v[208:211]
    v_mfma_f32_16x16x32_bf16 v[212:215], v[92:95], v[236:239], v[212:215]
    v_mfma_f32_16x16x32_bf16 v[216:219], v[108:111], v[236:239], v[216:219]
    v_mfma_f32_16x16x32_bf16 v[220:223], v[124:127], v[236:239], v[220:223]

    v_lshlrev_b32 v243, 10, v242
    v_lshlrev_b32 v244, 4, v241
    v_add_u32 v243, v243, v244
    s_lshl_b32 s76, s3, 14

    s_add_u32 s77, s76, 0
    buffer_load_dwordx4 v[224:227], v243, s[80:83], s77 offen nt
    s_add_u32 s77, s76, 4096
    buffer_load_dwordx4 v[228:231], v243, s[80:83], s77 offen nt
    s_add_u32 s77, s76, 8192
    buffer_load_dwordx4 v[232:235], v243, s[80:83], s77 offen nt
    s_add_u32 s77, s76, 12288
    buffer_load_dwordx4 v[236:239], v243, s[80:83], s77 offen nt
    s_nop 2
    v_max3_f32 v244, v192, v193, v194
    v_max3_f32 v245, v200, v201, v202
    v_max3_f32 v246, v208, v209, v210
    v_max3_f32 v247, v216, v217, v218
    v_max3_f32 v244, v244, v195, v196
    v_max3_f32 v245, v245, v203, v204
    v_max3_f32 v246, v246, v211, v212
    v_max3_f32 v247, v247, v219, v220
    v_max3_f32 v244, v244, v197, v198
    v_max3_f32 v245, v245, v205, v206
    v_max3_f32 v246, v246, v213, v214
    v_max3_f32 v247, v247, v221, v222
    v_max_f32 v244, v244, v199
    v_max_f32 v245, v245, v207
    v_max_f32 v246, v246, v215
    v_max_f32 v247, v247, v223

    v_max3_f32 v244, v244, v245, v246
    v_max_f32 v244, v244, v247
    v_mov_b32 v245, v244
    s_nop 1
    v_permlane16_swap_b32 v245, v244
    s_nop 1
    v_max_f32 v244, v244, v245
    v_mov_b32 v245, v244
    s_nop 1
    v_permlane32_swap_b32 v245, v244
    s_nop 1
    v_max_f32 v244, v244, v245
    s_mov_b32 s76, 1040356334
    v_mul_f32 v244, s76, v244

    v_fma_f32 v192, v192, s76, -v244
    v_fma_f32 v193, v193, s76, -v244
    v_fma_f32 v194, v194, s76, -v244
    v_fma_f32 v195, v195, s76, -v244
    v_fma_f32 v196, v196, s76, -v244
    v_fma_f32 v197, v197, s76, -v244
    v_fma_f32 v198, v198, s76, -v244
    v_fma_f32 v199, v199, s76, -v244
    v_fma_f32 v200, v200, s76, -v244
    v_fma_f32 v201, v201, s76, -v244
    v_fma_f32 v202, v202, s76, -v244
    v_fma_f32 v203, v203, s76, -v244
    v_fma_f32 v204, v204, s76, -v244
    v_fma_f32 v205, v205, s76, -v244
    v_fma_f32 v206, v206, s76, -v244
    v_fma_f32 v207, v207, s76, -v244
    v_fma_f32 v208, v208, s76, -v244
    v_fma_f32 v209, v209, s76, -v244
    v_fma_f32 v210, v210, s76, -v244
    v_fma_f32 v211, v211, s76, -v244
    v_fma_f32 v212, v212, s76, -v244
    v_fma_f32 v213, v213, s76, -v244
    v_fma_f32 v214, v214, s76, -v244
    v_fma_f32 v215, v215, s76, -v244
    v_fma_f32 v216, v216, s76, -v244
    v_fma_f32 v217, v217, s76, -v244
    v_fma_f32 v218, v218, s76, -v244
    v_fma_f32 v219, v219, s76, -v244
    v_fma_f32 v220, v220, s76, -v244
    v_fma_f32 v221, v221, s76, -v244
    v_fma_f32 v222, v222, s76, -v244
    v_fma_f32 v223, v223, s76, -v244
    v_exp_f32 v192, v192
    v_exp_f32 v193, v193
    v_exp_f32 v194, v194
    v_exp_f32 v195, v195
    v_exp_f32 v196, v196
    v_exp_f32 v197, v197
    v_exp_f32 v198, v198
    v_exp_f32 v199, v199
    v_exp_f32 v200, v200
    v_exp_f32 v201, v201
    v_exp_f32 v202, v202
    v_exp_f32 v203, v203
    v_exp_f32 v204, v204
    v_exp_f32 v205, v205
    v_exp_f32 v206, v206
    v_exp_f32 v207, v207
    v_exp_f32 v208, v208
    v_exp_f32 v209, v209
    v_exp_f32 v210, v210
    v_exp_f32 v211, v211
    v_exp_f32 v212, v212
    v_exp_f32 v213, v213
    v_exp_f32 v214, v214
    v_exp_f32 v215, v215
    v_exp_f32 v216, v216
    v_exp_f32 v217, v217
    v_exp_f32 v218, v218
    v_exp_f32 v219, v219
    v_exp_f32 v220, v220
    v_exp_f32 v221, v221
    v_exp_f32 v222, v222
    v_exp_f32 v223, v223
    s_nop 0
    v_cvt_pk_bf16_f32 v64, v192, v193
    v_cvt_pk_bf16_f32 v65, v194, v195
    v_cvt_pk_bf16_f32 v66, v196, v197
    v_cvt_pk_bf16_f32 v67, v198, v199
    v_cvt_pk_bf16_f32 v68, v200, v201
    v_cvt_pk_bf16_f32 v69, v202, v203
    v_cvt_pk_bf16_f32 v70, v204, v205
    v_cvt_pk_bf16_f32 v71, v206, v207
    v_cvt_pk_bf16_f32 v72, v208, v209
    v_cvt_pk_bf16_f32 v73, v210, v211
    v_cvt_pk_bf16_f32 v74, v212, v213
    v_cvt_pk_bf16_f32 v75, v214, v215
    v_cvt_pk_bf16_f32 v76, v216, v217
    v_cvt_pk_bf16_f32 v77, v218, v219
    v_cvt_pk_bf16_f32 v78, v220, v221
    v_cvt_pk_bf16_f32 v79, v222, v223

    s_mov_b32 s76, 0x05040100
    s_mov_b32 s77, 0x07060302

    s_waitcnt vmcnt(28)
    v_perm_b32 v192, v132, v128, s76
    v_perm_b32 v193, v140, v136, s76
    v_perm_b32 v194, v148, v144, s76
    v_perm_b32 v195, v156, v152, s76
    v_perm_b32 v196, v132, v128, s77
    v_perm_b32 v197, v140, v136, s77
    v_perm_b32 v198, v148, v144, s77
    v_perm_b32 v199, v156, v152, s77
    v_perm_b32 v200, v133, v129, s76
    v_perm_b32 v201, v141, v137, s76
    v_perm_b32 v202, v149, v145, s76
    v_perm_b32 v203, v157, v153, s76
    v_perm_b32 v204, v133, v129, s77
    v_perm_b32 v205, v141, v137, s77
    v_perm_b32 v206, v149, v145, s77
    v_perm_b32 v207, v157, v153, s77
    v_perm_b32 v208, v134, v130, s76
    v_perm_b32 v209, v142, v138, s76
    v_perm_b32 v210, v150, v146, s76
    v_perm_b32 v211, v158, v154, s76
    v_perm_b32 v212, v134, v130, s77
    v_perm_b32 v213, v142, v138, s77
    v_perm_b32 v214, v150, v146, s77
    v_perm_b32 v215, v158, v154, s77
    v_perm_b32 v216, v135, v131, s76
    v_perm_b32 v217, v143, v139, s76
    v_perm_b32 v218, v151, v147, s76
    v_perm_b32 v219, v159, v155, s76
    v_perm_b32 v220, v135, v131, s77
    v_perm_b32 v221, v143, v139, s77
    v_perm_b32 v222, v151, v147, s77
    v_perm_b32 v223, v159, v155, s77
    v_mfma_f32_16x16x32_bf16 v[112:115], v[64:67], v[248:251], 0
    v_mfma_f32_16x16x32_bf16 v[80:83], v[64:67], v[192:195], 0
    v_mfma_f32_16x16x32_bf16 v[84:87], v[64:67], v[196:199], 0
    v_mfma_f32_16x16x32_bf16 v[88:91], v[64:67], v[200:203], 0
    v_mfma_f32_16x16x32_bf16 v[92:95], v[64:67], v[204:207], 0
    v_mfma_f32_16x16x32_bf16 v[96:99], v[64:67], v[208:211], 0
    v_mfma_f32_16x16x32_bf16 v[100:103], v[64:67], v[212:215], 0
    v_mfma_f32_16x16x32_bf16 v[104:107], v[64:67], v[216:219], 0
    v_mfma_f32_16x16x32_bf16 v[108:111], v[64:67], v[220:223], 0
    s_waitcnt vmcnt(20)
    v_perm_b32 v192, v164, v160, s76
    v_perm_b32 v193, v172, v168, s76
    v_perm_b32 v194, v180, v176, s76
    v_perm_b32 v195, v188, v184, s76
    v_perm_b32 v196, v164, v160, s77
    v_perm_b32 v197, v172, v168, s77
    v_perm_b32 v198, v180, v176, s77
    v_perm_b32 v199, v188, v184, s77
    v_perm_b32 v200, v165, v161, s76
    v_perm_b32 v201, v173, v169, s76
    v_perm_b32 v202, v181, v177, s76
    v_perm_b32 v203, v189, v185, s76
    v_perm_b32 v204, v165, v161, s77
    v_perm_b32 v205, v173, v169, s77
    v_perm_b32 v206, v181, v177, s77
    v_perm_b32 v207, v189, v185, s77
    v_perm_b32 v208, v166, v162, s76
    v_perm_b32 v209, v174, v170, s76
    v_perm_b32 v210, v182, v178, s76
    v_perm_b32 v211, v190, v186, s76
    v_perm_b32 v212, v166, v162, s77
    v_perm_b32 v213, v174, v170, s77
    v_perm_b32 v214, v182, v178, s77
    v_perm_b32 v215, v190, v186, s77
    v_perm_b32 v216, v167, v163, s76
    v_perm_b32 v217, v175, v171, s76
    v_perm_b32 v218, v183, v179, s76
    v_perm_b32 v219, v191, v187, s76
    v_perm_b32 v220, v167, v163, s77
    v_perm_b32 v221, v175, v171, s77
    v_perm_b32 v222, v183, v179, s77
    v_perm_b32 v223, v191, v187, s77
    v_mfma_f32_16x16x32_bf16 v[112:115], v[68:71], v[248:251], v[112:115]
    v_mfma_f32_16x16x32_bf16 v[80:83], v[68:71], v[192:195], v[80:83]
    v_mfma_f32_16x16x32_bf16 v[84:87], v[68:71], v[196:199], v[84:87]
    v_mfma_f32_16x16x32_bf16 v[88:91], v[68:71], v[200:203], v[88:91]
    v_mfma_f32_16x16x32_bf16 v[92:95], v[68:71], v[204:207], v[92:95]
    v_mfma_f32_16x16x32_bf16 v[96:99], v[68:71], v[208:211], v[96:99]
    v_mfma_f32_16x16x32_bf16 v[100:103], v[68:71], v[212:215], v[100:103]
    v_mfma_f32_16x16x32_bf16 v[104:107], v[68:71], v[216:219], v[104:107]
    v_mfma_f32_16x16x32_bf16 v[108:111], v[68:71], v[220:223], v[108:111]
    s_waitcnt vmcnt(12)
    v_perm_b32 v192, v4, v0, s76
    v_perm_b32 v193, v12, v8, s76
    v_perm_b32 v194, v20, v16, s76
    v_perm_b32 v195, v28, v24, s76
    v_perm_b32 v196, v4, v0, s77
    v_perm_b32 v197, v12, v8, s77
    v_perm_b32 v198, v20, v16, s77
    v_perm_b32 v199, v28, v24, s77
    v_perm_b32 v200, v5, v1, s76
    v_perm_b32 v201, v13, v9, s76
    v_perm_b32 v202, v21, v17, s76
    v_perm_b32 v203, v29, v25, s76
    v_perm_b32 v204, v5, v1, s77
    v_perm_b32 v205, v13, v9, s77
    v_perm_b32 v206, v21, v17, s77
    v_perm_b32 v207, v29, v25, s77
    v_perm_b32 v208, v6, v2, s76
    v_perm_b32 v209, v14, v10, s76
    v_perm_b32 v210, v22, v18, s76
    v_perm_b32 v211, v30, v26, s76
    v_perm_b32 v212, v6, v2, s77
    v_perm_b32 v213, v14, v10, s77
    v_perm_b32 v214, v22, v18, s77
    v_perm_b32 v215, v30, v26, s77
    v_perm_b32 v216, v7, v3, s76
    v_perm_b32 v217, v15, v11, s76
    v_perm_b32 v218, v23, v19, s76
    v_perm_b32 v219, v31, v27, s76
    v_perm_b32 v220, v7, v3, s77
    v_perm_b32 v221, v15, v11, s77
    v_perm_b32 v222, v23, v19, s77
    v_perm_b32 v223, v31, v27, s77
    v_mfma_f32_16x16x32_bf16 v[112:115], v[72:75], v[248:251], v[112:115]
    v_mfma_f32_16x16x32_bf16 v[80:83], v[72:75], v[192:195], v[80:83]
    v_mfma_f32_16x16x32_bf16 v[84:87], v[72:75], v[196:199], v[84:87]
    v_mfma_f32_16x16x32_bf16 v[88:91], v[72:75], v[200:203], v[88:91]
    v_mfma_f32_16x16x32_bf16 v[92:95], v[72:75], v[204:207], v[92:95]
    v_mfma_f32_16x16x32_bf16 v[96:99], v[72:75], v[208:211], v[96:99]
    v_mfma_f32_16x16x32_bf16 v[100:103], v[72:75], v[212:215], v[100:103]
    v_mfma_f32_16x16x32_bf16 v[104:107], v[72:75], v[216:219], v[104:107]
    v_mfma_f32_16x16x32_bf16 v[108:111], v[72:75], v[220:223], v[108:111]
    s_waitcnt vmcnt(4)
    v_perm_b32 v192, v36, v32, s76
    v_perm_b32 v193, v44, v40, s76
    v_perm_b32 v194, v52, v48, s76
    v_perm_b32 v195, v60, v56, s76
    v_perm_b32 v196, v36, v32, s77
    v_perm_b32 v197, v44, v40, s77
    v_perm_b32 v198, v52, v48, s77
    v_perm_b32 v199, v60, v56, s77
    v_perm_b32 v200, v37, v33, s76
    v_perm_b32 v201, v45, v41, s76
    v_perm_b32 v202, v53, v49, s76
    v_perm_b32 v203, v61, v57, s76
    v_perm_b32 v204, v37, v33, s77
    v_perm_b32 v205, v45, v41, s77
    v_perm_b32 v206, v53, v49, s77
    v_perm_b32 v207, v61, v57, s77
    v_perm_b32 v208, v38, v34, s76
    v_perm_b32 v209, v46, v42, s76
    v_perm_b32 v210, v54, v50, s76
    v_perm_b32 v211, v62, v58, s76
    v_perm_b32 v212, v38, v34, s77
    v_perm_b32 v213, v46, v42, s77
    v_perm_b32 v214, v54, v50, s77
    v_perm_b32 v215, v62, v58, s77
    v_perm_b32 v216, v39, v35, s76
    v_perm_b32 v217, v47, v43, s76
    v_perm_b32 v218, v55, v51, s76
    v_perm_b32 v219, v63, v59, s76
    v_perm_b32 v220, v39, v35, s77
    v_perm_b32 v221, v47, v43, s77
    v_perm_b32 v222, v55, v51, s77
    v_perm_b32 v223, v63, v59, s77
    v_mfma_f32_16x16x32_bf16 v[112:115], v[76:79], v[248:251], v[112:115]
    v_mfma_f32_16x16x32_bf16 v[80:83], v[76:79], v[192:195], v[80:83]
    v_mfma_f32_16x16x32_bf16 v[84:87], v[76:79], v[196:199], v[84:87]
    v_mfma_f32_16x16x32_bf16 v[88:91], v[76:79], v[200:203], v[88:91]
    v_mfma_f32_16x16x32_bf16 v[92:95], v[76:79], v[204:207], v[92:95]
    v_mfma_f32_16x16x32_bf16 v[96:99], v[76:79], v[208:211], v[96:99]
    v_mfma_f32_16x16x32_bf16 v[100:103], v[76:79], v[212:215], v[100:103]
    v_mfma_f32_16x16x32_bf16 v[104:107], v[76:79], v[216:219], v[104:107]
    v_mfma_f32_16x16x32_bf16 v[108:111], v[76:79], v[220:223], v[108:111]

    s_mul_i32 s76, s3, 4608
    v_mul_u32_u24 v243, 288, v242
    v_lshlrev_b32 v245, 4, v241
    v_add_u32 v243, v243, v245
    v_add_u32 v243, s76, v243
    s_lshl_b32 s76, s3, 11
    v_lshlrev_b32 v245, 9, v242
    v_lshlrev_b32 v246, 5, v241
    v_add_u32 v245, v245, v246
    v_add_u32 v245, s76, v245
    s_lshl_b32 s76, s3, 3
    v_lshlrev_b32 v246, 6, v242
    v_add_u32 v246, s76, v246

    s_waitcnt vmcnt(0)
    ds_write_b128 v243, v[224:227] offset:20480
    ds_write_b128 v243, v[228:231] offset:21632
    ds_write_b128 v243, v[232:235] offset:22784
    ds_write_b128 v243, v[236:239] offset:23936
    v_mov_b32 v192, v80
    v_mov_b32 v193, v84
    v_mov_b32 v194, v88
    v_mov_b32 v195, v92
    v_mov_b32 v196, v96
    v_mov_b32 v197, v100
    v_mov_b32 v198, v104
    v_mov_b32 v199, v108

    v_mov_b32 v200, v244
    v_mov_b32 v201, v112
    ds_write_b128 v245, v[192:195] offset:4096
    ds_write_b128 v245, v[196:199] offset:4112
    s_mov_b32 exec_lo, 0x00100001
    s_mov_b32 exec_hi, 0x10000100
    ds_write_b64 v246, v[200:201] offset:1152
    s_mov_b64 exec, -1

    s_waitcnt lgkmcnt(0)
    s_barrier
    s_lshl_b32 s79, s79, 1
    v_mov_b32 v57, s101
    v_mov_b32 v59, s101
    s_cmp_gt_u32 s3, 3
    s_cbranch_scc1 L_tr

    s_lshl_b32 s76, s3, 6
    v_mov_b32 v244, s76
    s_lshl_b32 s76, s3, 9
    v_lshlrev_b32 v245, 3, v240
    v_add_u32 v245, s76, v245

    ds_read_b128 v[0:3], v244 offset:1152
    ds_read_b128 v[4:7], v244 offset:1168
    ds_read_b128 v[8:11], v244 offset:1184
    ds_read_b128 v[12:15], v244 offset:1200
    ds_read_b64 v[16:17], v245 offset:4096
    ds_read_b64 v[18:19], v245 offset:6144
    ds_read_b64 v[20:21], v245 offset:8192
    ds_read_b64 v[22:23], v245 offset:10240
    ds_read_b64 v[24:25], v245 offset:12288
    ds_read_b64 v[26:27], v245 offset:14336
    ds_read_b64 v[28:29], v245 offset:16384
    ds_read_b64 v[30:31], v245 offset:18432

    s_lshl_b32 s76, s3, 10
    s_add_u32 s76, s76, s79
    s_add_u32 s76, s76, 1048576
    s_lshr_b32 s77, s79, 14
    s_lshl_b32 s77, s77, 7
    s_lshl_b32 s78, s3, 5
    s_add_u32 s77, s77, s78
    s_lshl_b32 s78, s73, 4
    s_add_u32 s77, s77, s78
    s_add_u32 s77, s77, 589824
    s_waitcnt lgkmcnt(8)
    v_max3_f32 v48, v0, v2, v4
    v_max3_f32 v49, v6, v8, v10
    v_max3_f32 v48, v48, v12, v14
    v_max_f32 v48, v48, v49

    v_sub_f32 v0, v0, v48
    v_sub_f32 v2, v2, v48
    v_sub_f32 v4, v4, v48
    v_sub_f32 v6, v6, v48
    v_sub_f32 v8, v8, v48
    v_sub_f32 v10, v10, v48
    v_sub_f32 v12, v12, v48
    v_sub_f32 v14, v14, v48
    v_exp_f32 v0, v0
    v_exp_f32 v2, v2
    v_exp_f32 v4, v4
    v_exp_f32 v6, v6
    v_exp_f32 v8, v8
    v_exp_f32 v10, v10
    v_exp_f32 v12, v12
    v_exp_f32 v14, v14
    s_waitcnt lgkmcnt(0)
    v_mul_f32 v56, v0, v16
    v_mul_f32 v58, v0, v17
    v_mul_f32 v50, v0, v1
    v_fma_f32 v56, v2, v18, v56
    v_fma_f32 v58, v2, v19, v58
    v_fma_f32 v50, v2, v3, v50
    v_fma_f32 v56, v4, v20, v56
    v_fma_f32 v58, v4, v21, v58
    v_fma_f32 v50, v4, v5, v50
    v_fma_f32 v56, v6, v22, v56
    v_fma_f32 v58, v6, v23, v58
    v_fma_f32 v50, v6, v7, v50
    v_fma_f32 v56, v8, v24, v56
    v_fma_f32 v58, v8, v25, v58
    v_fma_f32 v50, v8, v9, v50
    v_fma_f32 v56, v10, v26, v56
    v_fma_f32 v58, v10, v27, v58
    v_fma_f32 v50, v10, v11, v50
    v_fma_f32 v56, v12, v28, v56
    v_fma_f32 v58, v12, v29, v58
    v_fma_f32 v50, v12, v13, v50
    v_fma_f32 v56, v14, v30, v56
    v_fma_f32 v58, v14, v31, v58
    v_fma_f32 v50, v14, v15, v50

    v_mov_b32 v49, s101
    v_mov_b32 v51, s101
    buffer_store_dwordx4 v[56:59], v255, s[32:35], s76 offen sc1
    v_mov_b32 v243, 0
    s_mov_b64 exec, 1
    buffer_store_dwordx4 v[48:51], v243, s[32:35], s77 offen sc1
    s_mov_b64 exec, -1
L_tr:
    s_lshl_b32 s76, s70, 4
    s_lshl_b32 s77, s3, 1
    s_add_u32 s76, s76, s77
    s_lshl_b32 s76, s76, 13
    s_add_u32 s76, s76, 1048576
    s_lshr_b32 s77, s71, 2
    s_lshl_b32 s78, s77, 10
    s_add_u32 s4, s76, s78
    s_add_u32 s5, s4, 8192
    s_lshl_b32 s78, s70, 3
    s_add_u32 s78, s78, s3
    s_lshl_b32 s78, s78, 7
    s_lshl_b32 s6, s77, 5
    s_add_u32 s6, s6, s78
    s_add_u32 s6, s6, 589824
    v_lshlrev_b32 v243, 4, v240
    v_mov_b32 v1, 0
    v_mov_b32 v3, 0
    s_mov_b32 s78, 4000

    s_mov_b64 exec, 3
    buffer_load_dwordx4 v[0:3], v243, s[32:35], s6 offen sc1
    s_mov_b64 exec, -1

    v_lshrrev_b32 v246, 2, v241
    v_lshlrev_b32 v244, 3, v242
    v_add_u32 v246, v246, v244
    v_mul_u32_u24 v246, 288, v246
    v_and_b32 v244, 3, v241
    v_lshlrev_b32 v244, 3, v244
    v_add_u32 v246, v246, v244
    s_lshl_b32 s76, s3, 5
    v_add_u32 v246, s76, v246

    ds_read_b64_tr_b16 v[128:129], v246 offset:20480
    ds_read_b64_tr_b16 v[130:131], v246 offset:21632
    ds_read_b64_tr_b16 v[132:133], v246 offset:29696
    ds_read_b64_tr_b16 v[134:135], v246 offset:30848
    ds_read_b64_tr_b16 v[136:137], v246 offset:38912
    ds_read_b64_tr_b16 v[138:139], v246 offset:40064
    ds_read_b64_tr_b16 v[140:141], v246 offset:48128
    ds_read_b64_tr_b16 v[142:143], v246 offset:49280

    s_mov_b64 exec, 3
L_h1:
    s_waitcnt vmcnt(0)
    v_cmp_ne_u32 vcc, s101, v1
    v_cmp_ne_u32 s[10:11], s101, v3
    s_nop 1
    s_or_b64 vcc, vcc, s[10:11]
    s_cbranch_vccz L_h1p
    s_sub_u32 s78, s78, 1
    s_cmp_eq_u32 s78, 0
    s_cbranch_scc1 L_h1p
    s_sleep 2
    buffer_load_dwordx4 v[0:3], v243, s[32:35], s6 offen sc1
    s_branch L_h1
L_h1p:
    s_mov_b64 exec, -1
    buffer_load_dwordx4 v[4:7], v255, s[32:35], s4 offen sc1
    buffer_load_dwordx4 v[8:11], v255, s[32:35], s5 offen sc1
    s_mov_b64 exec, 3
    s_waitcnt vmcnt(2)

    v_max_f32_dpp v12, v0, v0 quad_perm:[1,0,2,3] row_mask:0xf bank_mask:0xf
    v_sub_f32 v13, v0, v12
    v_exp_f32 v13, v13
    s_nop 0
    v_mul_f32 v14, v13, v2
    s_nop 1
    v_add_f32_dpp v14, v14, v14 quad_perm:[1,0,2,3] row_mask:0xf bank_mask:0xf
    v_rcp_f32 v14, v14
    s_nop 0
    v_mul_f32 v13, v13, v14
    s_nop 0
    v_readlane_b32 s8, v13, 0
    v_readlane_b32 s9, v13, 1

    s_mov_b64 exec, -1
L_h1q:
    s_waitcnt vmcnt(0)
    v_cmp_ne_u32 vcc, s101, v5
    v_cmp_ne_u32 s[10:11], s101, v7
    v_cmp_ne_u32 s[12:13], s101, v9
    v_cmp_ne_u32 s[14:15], s101, v11
    s_nop 1
    s_or_b64 vcc, vcc, s[10:11]
    s_or_b64 s[12:13], s[12:13], s[14:15]
    s_or_b64 vcc, vcc, s[12:13]
    s_cbranch_vccz L_h1go
    s_sub_u32 s78, s78, 1
    s_cmp_eq_u32 s78, 0
    s_cbranch_scc1 L_h1go
    buffer_load_dwordx4 v[4:7], v255, s[32:35], s4 offen sc1
    buffer_load_dwordx4 v[8:11], v255, s[32:35], s5 offen sc1
    s_branch L_h1q
L_h1go:

    v_mul_f32 v0, s8, v4
    v_mul_f32 v1, s8, v6
    v_fma_f32 v0, v8, s9, v0
    v_fma_f32 v1, v10, s9, v1
    v_cvt_pk_bf16_f32 v0, v0, v1
    s_mul_i32 s76, s3, 272
    v_lshlrev_b32 v243, 2, v240
    v_add_u32 v243, s76, v243
    ds_write_b32 v243, v0 offset:1408
    v_and_b32 v244, 7, v240
    v_mul_u32_u24 v245, 272, v244
    v_lshlrev_b32 v246, 4, v242
    v_add_u32 v245, v245, v246
    s_waitcnt lgkmcnt(0)
    s_barrier

    ds_read_b128 v[144:147], v245 offset:1408
    ds_read_b128 v[148:151], v245 offset:1472
    ds_read_b128 v[152:155], v245 offset:1536
    ds_read_b128 v[156:159], v245 offset:1600

    v_lshlrev_b32 v243, 7, v244
    v_lshlrev_b32 v246, 5, v242
    v_add_u32 v243, v243, v246
    v_lshrrev_b32 v246, 3, v241
    v_lshlrev_b32 v246, 4, v246
    v_add_u32 v243, v243, v246
    s_lshl_b32 s76, s3, 10
    s_add_u32 s76, s76, s79
    s_add_u32 s76, s76, 3145728
    s_mov_b32 s10, 0xff00ff00
    s_mov_b32 s11, 0xff00ff00
    v_mov_b32 v165, s101
    v_mov_b32 v167, s101

    s_waitcnt lgkmcnt(3)
    v_mfma_f32_16x16x32_bf16 v[160:163], v[128:131], v[144:147], 0
    s_waitcnt lgkmcnt(2)
    v_mfma_f32_16x16x32_bf16 v[160:163], v[132:135], v[148:151], v[160:163]
    s_waitcnt lgkmcnt(1)
    v_mfma_f32_16x16x32_bf16 v[160:163], v[136:139], v[152:155], v[160:163]
    s_waitcnt lgkmcnt(0)
    v_mfma_f32_16x16x32_bf16 v[160:163], v[140:143], v[156:159], v[160:163]

    s_nop 7
    v_cndmask_b32 v164, v160, v162, s[10:11]
    v_cndmask_b32 v166, v161, v163, s[10:11]
    buffer_store_dwordx4 v[164:167], v243, s[32:35], s76 offen sc1

    s_cmp_lg_u32 s3, 0
    s_cbranch_scc1 L_fin
    s_lshr_b32 s4, s2, 5
    s_and_b32 s5, s2, 31
    s_lshr_b32 s6, s5, 3
    s_and_b32 s7, s5, 7
    s_lshl_b32 s76, s6, 13
    s_lshl_b32 s77, s4, 7
    s_add_u32 s76, s76, s77
    s_lshl_b32 s77, s7, 10
    s_add_u32 s76, s76, s77
    s_add_u32 s8, s76, 3145728

    s_add_u32 s9, s8, 262144
    s_add_u32 s10, s8, 524288
    s_add_u32 s11, s8, 786432
    s_add_u32 s12, s8, 1048576
    s_add_u32 s13, s8, 1310720
    s_add_u32 s14, s8, 1572864
    s_add_u32 s15, s8, 1835008

    v_lshrrev_b32 v243, 3, v240
    v_lshlrev_b32 v243, 15, v243
    v_and_b32 v244, 7, v240
    v_lshlrev_b32 v244, 4, v244
    v_add_u32 v243, v243, v244

    v_mov_b32 v1, 0
    v_mov_b32 v3, 0
    v_mov_b32 v5, 0
    v_mov_b32 v7, 0
    v_mov_b32 v9, 0
    v_mov_b32 v11, 0
    v_mov_b32 v13, 0
    v_mov_b32 v15, 0
    v_mov_b32 v17, 0
    v_mov_b32 v19, 0
    v_mov_b32 v21, 0
    v_mov_b32 v23, 0
    v_mov_b32 v25, 0
    v_mov_b32 v27, 0
    v_mov_b32 v29, 0
    v_mov_b32 v31, 0
    buffer_load_dwordx4 v[0:3], v243, s[32:35], s8 offen sc1
    buffer_load_dwordx4 v[4:7], v243, s[32:35], s9 offen sc1
    buffer_load_dwordx4 v[8:11], v243, s[32:35], s10 offen sc1
    buffer_load_dwordx4 v[12:15], v243, s[32:35], s11 offen sc1
    buffer_load_dwordx4 v[16:19], v243, s[32:35], s12 offen sc1
    buffer_load_dwordx4 v[20:23], v243, s[32:35], s13 offen sc1
    buffer_load_dwordx4 v[24:27], v243, s[32:35], s14 offen sc1
    buffer_load_dwordx4 v[28:31], v243, s[32:35], s15 offen sc1

    v_mov_b32 v246, s100
    v_sub_f32 v247, 1.0, v246
    s_mov_b32 s16, 0
    s_mov_b32 s17, -1
    v_cndmask_b32 v246, v246, v247, s[16:17]
    s_mov_b32 s56, s84
    s_mov_b32 s57, s85
    s_mov_b32 s58, 8192
    s_mov_b32 s59, 0x00020000
    s_lshl_b32 s18, s4, 10
    s_lshl_b32 s19, s5, 5
    s_add_u32 s18, s18, s19
    s_mov_b32 s78, 4000

L_h2:
    s_waitcnt vmcnt(24)
    s_mov_b64 s[52:53], 0

    v_cmp_ne_u32 vcc, s101, v1
    v_cmp_ne_u32 s[36:37], s101, v3
    s_nop 0
    s_or_b64 s[36:37], vcc, s[36:37]
    s_or_b64 s[52:53], s[52:53], s[36:37]
    v_cmp_ne_u32 vcc, s101, v5
    v_cmp_ne_u32 s[38:39], s101, v7
    s_nop 0
    s_or_b64 s[38:39], vcc, s[38:39]
    s_or_b64 s[52:53], s[52:53], s[38:39]
    v_cmp_ne_u32 vcc, s101, v9
    v_cmp_ne_u32 s[40:41], s101, v11
    s_nop 0
    s_or_b64 s[40:41], vcc, s[40:41]
    s_or_b64 s[52:53], s[52:53], s[40:41]
    v_cmp_ne_u32 vcc, s101, v13
    v_cmp_ne_u32 s[42:43], s101, v15
    s_nop 0
    s_or_b64 s[42:43], vcc, s[42:43]
    s_or_b64 s[52:53], s[52:53], s[42:43]
    v_cmp_ne_u32 vcc, s101, v17
    v_cmp_ne_u32 s[44:45], s101, v19
    s_nop 0
    s_or_b64 s[44:45], vcc, s[44:45]
    s_or_b64 s[52:53], s[52:53], s[44:45]
    v_cmp_ne_u32 vcc, s101, v21
    v_cmp_ne_u32 s[46:47], s101, v23
    s_nop 0
    s_or_b64 s[46:47], vcc, s[46:47]
    s_or_b64 s[52:53], s[52:53], s[46:47]
    v_cmp_ne_u32 vcc, s101, v25
    v_cmp_ne_u32 s[48:49], s101, v27
    s_nop 0
    s_or_b64 s[48:49], vcc, s[48:49]
    s_or_b64 s[52:53], s[52:53], s[48:49]
    v_cmp_ne_u32 vcc, s101, v29
    v_cmp_ne_u32 s[50:51], s101, v31
    s_nop 0
    s_or_b64 s[50:51], vcc, s[50:51]
    s_or_b64 s[52:53], s[52:53], s[50:51]

    s_cbranch_scc0 L_h2chk
    s_sub_u32 s78, s78, 1
    s_cmp_eq_u32 s78, 0
    s_cbranch_scc1 L_h2go
    s_sleep 2

    s_mov_b64 exec, s[36:37]
    buffer_load_dwordx4 v[0:3], v243, s[32:35], s8 offen sc1
    s_mov_b64 exec, s[38:39]
    buffer_load_dwordx4 v[4:7], v243, s[32:35], s9 offen sc1
    s_mov_b64 exec, s[40:41]
    buffer_load_dwordx4 v[8:11], v243, s[32:35], s10 offen sc1
    s_mov_b64 exec, s[42:43]
    buffer_load_dwordx4 v[12:15], v243, s[32:35], s11 offen sc1
    s_mov_b64 exec, s[44:45]
    buffer_load_dwordx4 v[16:19], v243, s[32:35], s12 offen sc1
    s_mov_b64 exec, s[46:47]
    buffer_load_dwordx4 v[20:23], v243, s[32:35], s13 offen sc1
    s_mov_b64 exec, s[48:49]
    buffer_load_dwordx4 v[24:27], v243, s[32:35], s14 offen sc1
    s_mov_b64 exec, s[50:51]
    buffer_load_dwordx4 v[28:31], v243, s[32:35], s15 offen sc1

    s_mov_b64 exec, -1
    s_branch L_h2
L_h2chk:
    s_waitcnt vmcnt(0)
    s_mov_b64 s[52:53], 0

    v_cmp_ne_u32 vcc, s101, v1
    v_cmp_ne_u32 s[36:37], s101, v3
    s_nop 0
    s_or_b64 s[36:37], vcc, s[36:37]
    s_or_b64 s[52:53], s[52:53], s[36:37]
    v_cmp_ne_u32 vcc, s101, v5
    v_cmp_ne_u32 s[36:37], s101, v7
    s_nop 0
    s_or_b64 s[36:37], vcc, s[36:37]
    s_or_b64 s[52:53], s[52:53], s[36:37]
    v_cmp_ne_u32 vcc, s101, v9
    v_cmp_ne_u32 s[36:37], s101, v11
    s_nop 0
    s_or_b64 s[36:37], vcc, s[36:37]
    s_or_b64 s[52:53], s[52:53], s[36:37]
    v_cmp_ne_u32 vcc, s101, v13
    v_cmp_ne_u32 s[36:37], s101, v15
    s_nop 0
    s_or_b64 s[36:37], vcc, s[36:37]
    s_or_b64 s[52:53], s[52:53], s[36:37]
    v_cmp_ne_u32 vcc, s101, v17
    v_cmp_ne_u32 s[36:37], s101, v19
    s_nop 0
    s_or_b64 s[36:37], vcc, s[36:37]
    s_or_b64 s[52:53], s[52:53], s[36:37]
    v_cmp_ne_u32 vcc, s101, v21
    v_cmp_ne_u32 s[36:37], s101, v23
    s_nop 0
    s_or_b64 s[36:37], vcc, s[36:37]
    s_or_b64 s[52:53], s[52:53], s[36:37]
    v_cmp_ne_u32 vcc, s101, v25
    v_cmp_ne_u32 s[36:37], s101, v27
    s_nop 0
    s_or_b64 s[36:37], vcc, s[36:37]
    s_or_b64 s[52:53], s[52:53], s[36:37]
    v_cmp_ne_u32 vcc, s101, v29
    v_cmp_ne_u32 s[36:37], s101, v31
    s_nop 0
    s_or_b64 s[36:37], vcc, s[36:37]
    s_or_b64 s[52:53], s[52:53], s[36:37]

    s_cbranch_scc0 L_h2go
    s_sub_u32 s78, s78, 1
    s_cmp_eq_u32 s78, 0
    s_cbranch_scc0 L_h2
L_h2go:
    s_cmp_lg_u32 s2, 0
    s_cbranch_scc1 L_noep
    v_mov_b32 v40, s101
    v_mov_b32 v41, 0
    s_mov_b32 s44, 524288
    s_mov_b64 exec, 1
    buffer_store_dword v40, v41, s[32:35], s44 offen sc1
    s_mov_b64 exec, -1
L_noep:

    v_add_f32 v0, v0, v4
    v_add_f32 v8, v8, v12
    v_add_f32 v16, v16, v20
    v_add_f32 v24, v24, v28
    v_add_f32 v2, v2, v6
    v_add_f32 v10, v10, v14
    v_add_f32 v18, v18, v22
    v_add_f32 v26, v26, v30
    v_add_f32 v0, v0, v8
    v_add_f32 v16, v16, v24
    v_add_f32 v2, v2, v10
    v_add_f32 v18, v18, v26
    v_add_f32 v0, v0, v16
    v_add_f32 v2, v2, v18
    v_mul_f32 v0, v0, v246
    v_mul_f32 v2, v2, v246
    s_nop 1
    v_add_f32_dpp v0, v0, v0 row_ror:8 row_mask:0xf bank_mask:0xf
    v_add_f32_dpp v2, v2, v2 row_ror:8 row_mask:0xf bank_mask:0xf
    v_mov_b32 v4, v0
    v_mov_b32 v6, v2
    s_nop 1
    v_permlane16_swap_b32 v4, v0
    v_permlane16_swap_b32 v6, v2
    s_nop 1
    v_add_f32 v0, v0, v4
    v_add_f32 v2, v2, v6
    v_mov_b32 v4, v0
    v_mov_b32 v6, v2
    s_nop 1
    v_permlane32_swap_b32 v4, v0
    v_permlane32_swap_b32 v6, v2
    s_nop 1
    v_add_f32 v0, v0, v4
    v_add_f32 v2, v2, v6

    v_cvt_pk_bf16_f32 v0, v0, v2
    v_lshlrev_b32 v243, 2, v240
    s_mov_b64 exec, 0xff
    buffer_store_dword v0, v243, s[56:59], s18 offen
    s_mov_b64 exec, -1
L_fin:

    s_waitcnt vmcnt(0)
L_end:

s_endpgm
.section .rodata,"a"
.p2align 6
.amdhsa_kernel gated_mix__sliding_block_cached__sliding_block_cached__decode_kernel
  .amdhsa_next_free_vgpr 256
  .amdhsa_next_free_sgpr 102
  .amdhsa_accum_offset 256
  .amdhsa_group_segment_fixed_size 0
  .amdhsa_kernarg_size 112
  .amdhsa_user_sgpr_count 2
  .amdhsa_user_sgpr_kernarg_segment_ptr 1
  .amdhsa_system_sgpr_workgroup_id_x 1
.end_amdhsa_kernel
```
